```python
import torch

def _softmax(x, axis=-1):
    return torch.softmax(x, dim=axis)
def _gelu(x):
    return torch.nn.functional.gelu(x, approximate="tanh")
def _silu(x):
    return torch.nn.functional.silu(x)
def _sigmoid(x):
    return torch.sigmoid(x)
def _layernorm(x, axis=-1, eps=1e-5):
    m = x.mean(dim=axis, keepdim=True)
    v = x.var(dim=axis, keepdim=True, unbiased=False)
    return (x - m) / torch.sqrt(v + eps)
def _scatter_add(tgt, idx, src, axis=0):
    return tgt.clone().index_add_(axis, idx, src)
def _segment_sum(src, seg, n):
    out = torch.zeros((n,) + src.shape[1:], dtype=src.dtype)
    return out.index_add_(0, seg, src)
def _pad(x, pw):
    flat = tuple(v for pair in reversed(pw) for v in pair)
    return torch.nn.functional.pad(x, flat)

kernel_name = 'sequential_preLN__sliding_block_cached__dense_activation_relu__decode'

def setup_inputs():

    _w = (lambda a: (lambda t: t.to(torch.bfloat16) if t.is_floating_point() else t)(torch.as_tensor(a)))
    def _A_setup():
        B, Sq, D = 1, 1, 640
        Hq, Hkv, Sk, Dh = 32, 32, 4096, 128
        assert Hq % Hkv == 0, (Hq, Hkv)
        return {
            "x": _w((lambda *s: torch.randn(*s, dtype=torch.bfloat16) * 0.05)(B, Sq, D)),
            "k_cache": _w((lambda *s: torch.randn(*s, dtype=torch.bfloat16) * 3.2)(B, Hkv, Sk, Dh)),
            "v_cache": _w((lambda *s: torch.randn(*s, dtype=torch.bfloat16) * 0.4)(B, Hkv, Sk, Dh)),
            "wq": _w((lambda *s: torch.randn(*s, dtype=torch.bfloat16) * 3.2)(D, Hq * Dh) * (D ** -0.5)),
            "wo": _w((lambda *s: torch.randn(*s, dtype=torch.bfloat16) * 0.4)(Hq * Dh, D) * ((Hq * Dh) ** -0.5)),
        }
    _A_in = _A_setup()

    def _B_setup():
        B, S, D, Dff = 1, 1, 640, 1728
        return {
            "x": _w((lambda *s: torch.randn(*s, dtype=torch.bfloat16) * 0.05)(B, S, D)),
            "w1": _w((lambda *s: torch.randn(*s, dtype=torch.bfloat16) * 0.05)(D, Dff)),
            "w2": _w((lambda *s: torch.randn(*s, dtype=torch.bfloat16) * 0.05)(Dff, D)),
        }
    _B_in = _B_setup()

    return {
        "A_x": _A_in["x"],
        "A_k_cache": _A_in["k_cache"],
        "A_v_cache": _A_in["v_cache"],
        "A_wq": _A_in["wq"],
        "A_wo": _A_in["wo"],
        "B_x": _B_in["x"],
        "B_w1": _B_in["w1"],
        "B_w2": _B_in["w2"],
    }

def reference(A_x, A_k_cache, A_v_cache, A_wq, A_wo, B_x, B_w1, B_w2):
    def _A_ref(x, k_cache, v_cache, wq, wo):
        B, Sq, D = x.shape
        Hq, Dh = 32, 128
        Hkv, Sk = k_cache.shape[1], k_cache.shape[2]
        W = min(4096, max(256, Sk // 4))
        rep = Hq // Hkv
        q = (lambda x, *d: x.permute(*d))((x @ wq).reshape(B, Sq, Hq, Dh), 0, 2, 1, 3)
        k = (lambda x, n, axis: torch.repeat_interleave(x, n, dim=axis))(k_cache[:, :, Sk - W:, :], rep, axis=1)
        v = (lambda x, n, axis: torch.repeat_interleave(x, n, dim=axis))(v_cache[:, :, Sk - W:, :], rep, axis=1)
        scores = torch.einsum("bhqd,bhkd->bhqk", q, k) * (Dh ** -0.5)
        p = _softmax(scores, axis=-1)
        o = torch.einsum("bhqk,bhkd->bhqd", p, v)
        return (lambda x, *d: x.permute(*d))(o, 0, 2, 1, 3).reshape(B, Sq, Hq * Dh) @ wo

    def _B_ref(x, w1, w2):
        h = torch.einsum("bsd,df->bsf", x, w1)
        zero = torch.zeros_like(h)
        h = torch.maximum(h, zero)
        return torch.einsum("bsf,fd->bsd", h, w2)

    x = A_x
    h = x + _A_ref(_layernorm(x, axis=-1), A_k_cache, A_v_cache, A_wq, A_wo)
    h2 = h + _B_ref(_layernorm(h, axis=-1), B_w1, B_w2)
    return h2
```

```asm
; @launch grid=(256,1,1) block=(256,1,1) lds=95232
.amdgcn_target "amdgcn-amd-amdhsa--gfx950"
.text
.globl sequential_preLN__sliding_block_cached__dense_activation_relu__decode_kernel
.p2align 8
.type sequential_preLN__sliding_block_cached__dense_activation_relu__decode_kernel,@function
sequential_preLN__sliding_block_cached__dense_activation_relu__decode_kernel:
    s_load_dwordx16 s[4:19], s[0:1], 0
    s_load_dwordx2 s[24:25], s[0:1], 80
    s_getpc_b64 s[34:35]
    s_lshl_b32 s32, s2, 6
    v_lshrrev_b32 v249, 6, v0
    v_lshl_add_u32 v248, v249, 7, s32
    s_cmpk_ge_u32 s2, 0x100
    s_cbranch_scc1 L_END
    global_load_dword v255, v248, s[34:35]
    s_lshr_b32 s33, s2, 5
    s_and_b32 s30, s2, 31
    s_lshl_b32 s32, s30, 8
    s_mulk_i32 s33, 160
    s_lshl_b32 s36, s33, 12
    s_add_u32 s36, s36, s32
    v_lshrrev_b32 v2, 4, v0
    v_and_b32 v3, 15, v0
    v_and_b32 v1, 63, v0
    v_lshlrev_b32 v220, 4, v1
    v_lshlrev_b32 v221, 2, v1
    v_lshl_add_u32 v222, v2, 3, s33
    v_lshl_add_u32 v223, v2, 1, s33
    v_lshl_add_u32 v248, v3, 4, s36
    v_lshl_add_u32 v224, v2, 15, v248
    s_movk_i32 s37, 0x2000
    v_add_u32 v225, s37, v224
    v_add_u32 v226, s37, v225
    v_add_u32 v227, s37, v226
    v_lshl_add_u32 v228, v2, 13, v248
    v_add_u32 v228, 0x80000, v228
    s_waitcnt lgkmcnt(0)
    s_load_dword s27, s[24:25], 0
    global_load_dwordx4 v[92:95], v220, s[4:5]
    global_load_dword v96, v221, s[4:5] offset:1024
    global_load_dwordx2 v[98:99], v222, s[4:5]
    global_load_ushort v100, v223, s[4:5] offset:128
    global_load_dwordx4 v[8:11], v224, s[10:11] nt
    global_load_dwordx4 v[12:15], v225, s[10:11] nt
    global_load_dwordx4 v[16:19], v226, s[10:11] nt
    global_load_dwordx4 v[20:23], v227, s[10:11] nt
    global_load_dwordx4 v[24:27], v228, s[10:11] nt
    s_lshr_b32 s31, s2, 5
    v_readfirstlane_b32 s26, v249
    s_and_b32 s30, s2, 31
    s_lshr_b32 s29, s2, 3
    v_and_b32 v4, 3, v2
    s_lshl_b32 s37, s30, 20
    s_lshl_b32 s34, s31, 15
    s_add_u32 s37, s37, s34
    s_lshl_b32 s34, s26, 13
    s_add_u32 s37, s37, s34
    s_add_u32 s37, s37, 786432
    v_lshrrev_b32 v248, 2, v3
    v_and_b32 v249, 3, v3
    v_lshl_add_u32 v229, v248, 8, s37
    v_lshl_add_u32 v229, v4, 6, v229
    v_lshl_add_u32 v229, v249, 4, v229
    s_add_u32 s38, s30, s31
    s_lshl1_add_u32 s38, s26, s38
    s_lshl_b32 s38, s38, 10
    s_and_b32 s38, s38, 0x1c00
    v_xor_b32 v229, s38, v229
    global_load_dwordx4 v[28:31], v229, s[6:7] nt
    v_xor_b32 v242, 1024, v229
    global_load_dwordx4 v[32:35], v242, s[6:7] nt
    v_xor_b32 v243, 2048, v229
    global_load_dwordx4 v[36:39], v243, s[6:7] nt
    v_lshl_add_u32 v230, v3, 4, s37
    v_lshl_add_u32 v230, v4, 10, v230
    v_xor_b32 v230, s38, v230
    s_and_b32 s28, s2, 7
    v_mov_b32 v156, 0
    v_mov_b32 v157, 0
    v_mov_b32 v158, 0
    v_mov_b32 v159, 0
    v_lshlrev_b32 v248, 4, v0
    ds_write_b128 v248, v[156:159] offset:9216
    s_mov_b32 s98, 0x3f803f80
    s_add_u32 s100, s24, 851968
    s_addc_u32 s101, s25, 0
    s_mov_b32 s40, 0x07060501
    s_mov_b32 s41, 0x07060502
    s_mov_b32 s42, 0x07060503
    s_mov_b32 s43, 0x0c04000c
    s_mov_b32 s44, 0xffff0000
    s_mov_b32 s45, 0xffff0000
    s_mov_b32 s46, 0
    s_mov_b32 s47, -1
    s_mov_b32 s51, 1069066811
    s_mov_b32 s52, 1035273459
    v_and_b32 v248, 1, v3
    v_lshlrev_b32 v248, 4, v248
    v_mov_b32 v249, 0xffff
    v_lshlrev_b32 v248, v248, v249
    v_lshrrev_b32 v249, 1, v3
    v_cmp_eq_u32 vcc, 0, v249
    s_nop 1
    v_cndmask_b32 v104, 0, v248, vcc
    v_cmp_eq_u32 vcc, 1, v249
    s_nop 1
    v_cndmask_b32 v105, 0, v248, vcc
    v_cmp_eq_u32 vcc, 2, v249
    s_nop 1
    v_cndmask_b32 v106, 0, v248, vcc
    v_cmp_eq_u32 vcc, 3, v249
    s_nop 1
    v_cndmask_b32 v107, 0, v248, vcc
    s_lshl_b32 s32, s26, 9
    v_lshl_add_u32 v231, v3, 5, s32
    v_lshl_add_u32 v231, v4, 4, v231
    s_lshl_b32 s32, s26, 7
    v_lshl_add_u32 v232, v1, 4, s32
    s_lshl3_add_u32 s34, s30, s31
    s_lshl_b32 s34, s34, 9
    s_add_u32 s34, s34, 65536
    v_add_u32 v233, s34, v232
    s_mov_b64 exec, 1
    global_load_dword v140, v233, s[100:101] nt
    s_mov_b64 exec, -1
    s_waitcnt vmcnt(11)
    v_dot2_f32_bf16 v248, v92, s98, 0
    v_dot2_f32_bf16 v250, v92, v92, 0
    v_dot2_f32_bf16 v248, v93, s98, v248
    v_dot2_f32_bf16 v250, v93, v93, v250
    v_dot2_f32_bf16 v248, v94, s98, v248
    v_dot2_f32_bf16 v250, v94, v94, v250
    v_dot2_f32_bf16 v248, v95, s98, v248
    v_dot2_f32_bf16 v250, v95, v95, v250
    v_dot2_f32_bf16 v248, v96, s98, v248
    v_dot2_f32_bf16 v250, v96, v96, v250
    s_waitcnt vmcnt(9)
    v_lshlrev_b32 v128, 16, v98
    v_and_b32 v129, 0xffff0000, v98
    v_add_f32_dpp v248, v248, v248 row_ror:8 row_mask:0xf bank_mask:0xf
    v_add_f32_dpp v250, v250, v250 row_ror:8 row_mask:0xf bank_mask:0xf
    v_lshlrev_b32 v130, 16, v99
    v_add_f32_dpp v248, v248, v248 row_ror:4 row_mask:0xf bank_mask:0xf
    v_add_f32_dpp v250, v250, v250 row_ror:4 row_mask:0xf bank_mask:0xf
    v_and_b32 v131, 0xffff0000, v99
    v_add_f32_dpp v248, v248, v248 row_ror:2 row_mask:0xf bank_mask:0xf
    v_add_f32_dpp v250, v250, v250 row_ror:2 row_mask:0xf bank_mask:0xf
    v_lshlrev_b32 v132, 16, v100
    v_add_f32_dpp v248, v248, v248 row_ror:1 row_mask:0xf bank_mask:0xf
    v_add_f32_dpp v250, v250, v250 row_ror:1 row_mask:0xf bank_mask:0xf
    s_nop 1
    v_permlane16_swap_b32 v248, v250
    v_add_f32 v248, v248, v250
    v_mov_b32 v250, v248
    s_nop 1
    v_permlane32_swap_b32 v248, v250
    v_add_f32 v248, v248, v250
    v_mul_f32 v248, 986500301, v248
    v_mov_b32 v250, v248
    s_nop 1
    v_permlane16_swap_b32 v248, v250
    v_fma_f32 v250, -v248, v248, v250
    v_max_f32 v250, 0, v250
    v_cvt_pk_bf16_f32 v248, v248, v250
    v_and_b32 v250, 0xffff0000, v248
    v_lshlrev_b32 v248, 16, v248
    v_add_f32 v250, 925353388, v250
    v_cvt_pk_bf16_f32 v250, v250, v250
    v_and_b32 v250, 0xffff0000, v250
    v_sqrt_f32 v250, v250
    v_sub_f32 v128, v128, v248
    v_sub_f32 v129, v129, v248
    v_sub_f32 v130, v130, v248
    v_sub_f32 v131, v131, v248
    v_sub_f32 v132, v132, v248
    v_cvt_pk_bf16_f32 v250, v250, v250
    v_and_b32 v250, 0xffff0000, v250
    v_rcp_f32 v250, v250
    v_cvt_pk_bf16_f32 v129, v128, v129
    v_cvt_pk_bf16_f32 v131, v130, v131
    v_cvt_pk_bf16_f32 v132, v132, v132
    v_lshlrev_b32 v128, 16, v129
    v_and_b32 v129, 0xffff0000, v129
    v_lshlrev_b32 v130, 16, v131
    v_and_b32 v131, 0xffff0000, v131
    v_lshlrev_b32 v132, 16, v132
    v_pk_mul_f32 v[128:129], v[128:129], v[250:251] op_sel_hi:[1,0]
    v_pk_mul_f32 v[130:131], v[130:131], v[250:251] op_sel_hi:[1,0]
    v_mul_f32 v132, v132, v250
    v_cvt_pk_bf16_f32 v128, v128, v128
    v_cvt_pk_bf16_f32 v129, v129, v129
    v_cvt_pk_bf16_f32 v130, v130, v130
    v_cvt_pk_bf16_f32 v131, v131, v131
    v_cvt_pk_bf16_f32 v132, v132, v132
    v_and_b32 v108, v128, v104
    v_and_b32 v109, v128, v105
    v_and_b32 v110, v128, v106
    v_and_b32 v111, v128, v107
    v_and_b32 v112, v129, v104
    v_and_b32 v113, v129, v105
    v_and_b32 v114, v129, v106
    v_and_b32 v115, v129, v107
    v_and_b32 v116, v130, v104
    v_and_b32 v117, v130, v105
    v_and_b32 v118, v130, v106
    v_and_b32 v119, v130, v107
    v_and_b32 v120, v131, v104
    v_and_b32 v121, v131, v105
    v_and_b32 v122, v131, v106
    v_and_b32 v123, v131, v107
    v_and_b32 v124, v132, v104
    v_and_b32 v125, v132, v105
    v_and_b32 v126, v132, v106
    v_and_b32 v127, v132, v107
    s_waitcnt vmcnt(8)
    v_mfma_f32_16x16x32_bf16 v[136:139], v[108:111], v[8:11], 0
    s_waitcnt vmcnt(7)
    v_mfma_f32_16x16x32_bf16 v[136:139], v[112:115], v[12:15], v[136:139]
    s_waitcnt vmcnt(6)
    v_mfma_f32_16x16x32_bf16 v[136:139], v[116:119], v[16:19], v[136:139]
    s_waitcnt vmcnt(5)
    v_mfma_f32_16x16x32_bf16 v[136:139], v[120:123], v[20:23], v[136:139]
    s_waitcnt vmcnt(4)
    v_mfma_f32_16x16x32_bf16 v[136:139], v[124:127], v[24:27], v[136:139]
    v_xor_b32 v242, 3072, v229
    global_load_dwordx4 v[40:43], v242, s[6:7] nt
    v_xor_b32 v243, 4096, v229
    global_load_dwordx4 v[44:47], v243, s[6:7] nt
    s_mov_b32 exec_hi, 0
    s_nop 2
    ds_write_b128 v231, v[136:139] offset:0
    s_waitcnt lgkmcnt(0)
    s_add_u32 s27, s27, 0x01010101
    s_max_u32 s27, s27, 1
    s_mov_b64 exec, -1
    v_mov_b32 v247, s27
    s_mov_b64 exec, 0xff
    s_barrier
    ds_read_b128 v[108:111], v232 offset:0
    ds_read_b128 v[112:115], v232 offset:512
    ds_read_b128 v[116:119], v232 offset:1024
    ds_read_b128 v[120:123], v232 offset:1536
    s_waitcnt lgkmcnt(0)
    v_pk_add_f32 v[108:109], v[108:109], v[112:113]
    v_pk_add_f32 v[110:111], v[110:111], v[114:115]
    v_pk_add_f32 v[116:117], v[116:117], v[120:121]
    v_pk_add_f32 v[118:119], v[118:119], v[122:123]
    v_pk_add_f32 v[108:109], v[108:109], v[116:117]
    v_pk_add_f32 v[110:111], v[110:111], v[118:119]
    v_perm_b32 v244, v108, v111, s40
    v_perm_b32 v245, v109, v111, s41
    v_perm_b32 v246, v110, v111, s42
    global_store_dwordx4 v233, v[244:247], s[100:101]
    global_store_dwordx4 v233, v[244:247], s[24:25] sc1
    s_mov_b64 exec, -1
    v_xor_b32 v242, 5120, v229
    global_load_dwordx4 v[48:51], v242, s[6:7] nt
    v_xor_b32 v243, 6144, v229
    global_load_dwordx4 v[52:55], v243, s[6:7] nt
    v_xor_b32 v242, 7168, v229
    global_load_dwordx4 v[56:59], v242, s[6:7] nt
    s_lshl_b32 s32, s26, 7
    s_lshl_b32 s33, s30, 3
    s_add_u32 s33, s33, s31
    s_lshl_b32 s34, s30, 12
    s_add_u32 s34, s34, 65536
    s_add_u32 s34, s34, s32
    v_lshrrev_b32 v248, 3, v1
    v_and_b32 v249, 7, v1
    v_lshl_add_u32 v234, v248, 9, s34
    v_lshl_add_u32 v234, v249, 4, v234
    s_lshl_b32 s34, s26, 8
    s_add_u32 s34, s34, 9408
    v_lshl_add_u32 v235, v249, 3, s34
    v_and_b32 v248, 1, v4
    v_lshl_add_u32 v235, v248, 2, v235
    v_and_b32 v248, 2, v4
    v_add_u32 v235, v248, v235
    v_lshlrev_b32 v236, 4, v4
    v_lshlrev_b32 v241, 4, v1
    s_mul_i32 s34, s26, 528
    s_add_u32 s34, s34, 2560
    v_lshl_add_u32 v237, v3, 5, s34
    v_lshl_add_u32 v237, v4, 4, v237
    s_add_u32 s34, s34, 512
    v_mov_b32 v248, s34
    v_cndmask_b32 v237, v237, v248, s[46:47]

    s_lshl3_add_u32 s33, s30, s31
    v_mov_b32 v248, 512
    v_cmp_gt_u32 vcc, 8, v1
    s_nop 1
    v_cndmask_b32 v238, v248, v232, vcc
    v_lshl_add_u32 v248, v1, 4, v248
    v_subrev_u32 v248, 128, v248
    v_cndmask_b32 v239, v248, v232, vcc
    s_mul_i32 s34, s33, 640
    s_add_u32 s34, s34, 262144
    v_add_u32 v239, s34, v239
    s_movk_i32 s92, 0xff
    s_cmp_eq_u32 s26, 0
    s_cselect_b32 s92, 0xffff, s92
    s_mov_b32 s93, 0
    s_mov_b64 s[90:91], 0
    s_mov_b32 s99, 0
    s_mov_b32 s50, 0
    s_mov_b32 s49, s29
    s_mov_b64 s[54:55], s[12:13]
    s_mov_b64 s[58:59], -1
    s_mov_b32 s53, 20480
    s_mov_b32 s95, 20480
    s_movk_i32 s97, 1024
    s_mov_b32 s32, 1280
    s_lshl3_add_u32 s33, s26, s28
    s_mul_i32 s33, s33, 163840
    s_lshl_b32 s34, s29, 6
    s_add_u32 s33, s33, s34
    s_bitcmp1_b32 s29, 0
    s_cselect_b32 s94, 4294823936, s53
    s_cselect_b32 s96, 4294960128, s97
    s_cselect_b32 s35, 81920, 0
    s_cselect_b32 s36, 4096, 0
    s_cmp_lt_u32 s29, 20
    s_cbranch_scc1 L_ROLE_DONE
    s_movk_i32 s96, 1024
    s_sub_u32 s34, s29, 20
    s_lshr_b32 s35, s34, 1
    s_lshl3_add_u32 s35, s35, s28
    s_cmp_lt_u32 s35, 27
    s_cbranch_scc0 L_ROLE_NOTMLP

    s_and_b32 s34, s34, 1
    s_lshl1_add_u32 s49, s35, s34
    s_mov_b32 s50, 1
    s_mov_b64 s[54:55], s[16:17]
    s_mov_b32 s53, 55296
    s_mov_b32 s94, s53
    s_movk_i32 s32, 3456
    s_mul_i32 s33, s26, 552960
    s_lshl_b32 s34, s49, 6
    s_add_u32 s33, s33, s34
    s_bitcmp1_b32 s29, 0
    s_cselect_b32 s95, 4294469632, s53
    s_cselect_b32 s97, 4294958080, s96
    s_cselect_b32 s35, 276480, 0
    s_cselect_b32 s36, 5120, 0

    s_branch L_ROLE_DONE
L_ROLE_NOTMLP:
    s_mov_b64 s[54:55], s[18:19]
    s_movk_i32 s32, 128
    s_mov_b32 s36, 0
    s_sub_u32 s34, s29, 28
    s_lshl3_add_u32 s49, s34, s28
    s_cmp_lt_u32 s49, 20
    s_cselect_b32 s50, 2, 3
    s_sub_u32 s90, s29, 26
    s_min_u32 s90, s90, 2
    s_lshl3_add_u32 s90, s90, s28
    s_lshl_b32 s90, s90, 7
    s_mul_i32 s91, s49, 81920
    s_cmp_lt_u32 s49, 27
    s_cselect_b32 s91, s91, s90
    s_movk_i32 s90, 3456
    s_cselect_b32 s90, 128, s90
    s_cselect_b64 s[54:55], s[18:19], s[16:17]
    s_cselect_b32 s99, 1, 1
    s_cmp_lt_u32 s49, 0
    s_cselect_b64 s[58:59], -1, 1
    s_cselect_b32 s53, 2048, 0
    s_cselect_b32 s33, s49, 0
    s_mov_b32 s94, s53
    s_mov_b32 s95, s53
    s_mul_i32 s33, s33, 81920
    s_mul_i32 s35, s26, 20480
L_ROLE_DONE:
    s_add_u32 s33, s33, s35
    s_mul_i32 s35, s26, 10240
    s_add_u32 s36, s36, s35
    s_add_u32 m0, s36, 13312
    v_lshrrev_b32 v248, 2, v1
    s_cmp_eq_u32 s50, 0
    s_cselect_b32 s35, 2, 0
    v_lshrrev_b32 v249, 1, v248
    v_xor_b32 v249, v249, v248
    v_and_b32 v249, s35, v249
    v_mul_u32_u24 v249, 3, v249
    v_xor_b32 v248, v249, v248
    v_mul_u32_u24 v240, s32, v248
    v_and_b32 v248, 3, v1
    v_lshl_add_u32 v240, v248, 4, v240
    v_add_u32 v240, s33, v240
    s_lshr_b32 s33, s2, 5
    s_mul_i32 s33, s33, 20480
    s_bfe_u32 s34, s2, 0x20003
    s_lshl2_add_u32 s34, s28, s34
    s_mul_i32 s34, s34, 640
    s_add_u32 s33, s33, s34
    s_add_u32 s33, s33, 720896
    s_mul_i32 s34, s2, 640
    s_add_u32 s34, s34, 524288
    s_bitcmp1_b32 s26, 0
    s_cselect_b32 s33, s33, s34
    v_add_u32 v248, s33, v220
    s_mov_b32 exec_hi, 0xff
    s_bitcmp1_b32 6, s26
    s_cselect_b64 exec, exec, 0
    global_store_dwordx4 v248, v[156:159], s[24:25] sc1
    s_mov_b64 exec, -1
    s_mov_b64 exec, s[92:93]
    global_load_dword v141, v239, s[100:101] sc1
    s_mov_b64 exec, -1
    s_waitcnt vmcnt(8)
    global_load_dwordx4 v[60:63], v230, s[8:9] nt
    s_waitcnt vmcnt(8)
    v_xor_b32 v243, 4096, v230
    global_load_dwordx4 v[64:67], v243, s[8:9] nt
    s_waitcnt vmcnt(8)
    global_load_dwordx4 v[108:111], v234, s[100:101] nt
    s_waitcnt vmcnt(8)
    v_xor_b32 v242, 256, v230
    global_load_dwordx4 v[68:71], v242, s[8:9] nt
    s_waitcnt vmcnt(8)
    v_xor_b32 v243, 4352, v230
    global_load_dwordx4 v[72:75], v243, s[8:9] nt
    s_waitcnt vmcnt(8)
    global_load_dwordx4 v[144:147], v234, s[100:101] nt
    s_waitcnt vmcnt(8)
    v_xor_b32 v242, 512, v230
    global_load_dwordx4 v[76:79], v242, s[8:9] nt
    s_waitcnt vmcnt(8)
    v_xor_b32 v243, 4608, v230
    global_load_dwordx4 v[80:83], v243, s[8:9] nt
    s_waitcnt vmcnt(8)
    v_xor_b32 v242, 768, v230
    global_load_dwordx4 v[84:87], v242, s[8:9] nt
    s_waitcnt vmcnt(8)
    v_xor_b32 v243, 4864, v230
    global_load_dwordx4 v[88:91], v243, s[8:9] nt
    s_waitcnt vmcnt(8)
    global_load_dwordx4 v[148:151], v234, s[100:101] nt
    s_movk_i32 s48, 32767
    s_waitcnt vmcnt(8)
    v_cmp_ne_u32 vcc, s27, v111
    s_cbranch_vccz L_QOK
    s_waitcnt vmcnt(5)
    v_cmp_ne_u32 vcc, s27, v147
    v_mov_b32 v108, v144
    v_mov_b32 v109, v145
    v_mov_b32 v110, v146
    s_cbranch_vccz L_QOK
    s_waitcnt vmcnt(0)
    v_cmp_ne_u32 vcc, s27, v151
    v_mov_b32 v108, v148
    v_mov_b32 v109, v149
    v_mov_b32 v110, v150
    s_cbranch_vccz L_QOK
L_QPOLL:
    s_sub_u32 s48, s48, 1
    s_cbranch_scc1 L_QOK
    s_and_b32 s33, s48, 63
    s_cbranch_scc1 L_QFAST
    global_load_dwordx4 v[108:111], v234, s[24:25] sc1
    s_branch L_QCHK
L_QFAST:
    global_load_dwordx4 v[108:111], v234, s[100:101] nt
L_QCHK:
    s_waitcnt vmcnt(0)
    v_cmp_ne_u32 vcc, s27, v111
    s_cbranch_vccnz L_QPOLL
L_QOK:
    v_perm_b32 v111, v109, v108, s43
    v_lshl_or_b32 v111, v110, 24, v111
    v_permlane32_swap_b32 v108, v109
    s_nop 0
    v_permlane32_swap_b32 v110, v111
    v_add_f32 v108, v108, v109
    v_add_f32 v110, v110, v111
    s_nop 1
    v_permlane16_swap_b32 v108, v110
    v_add_f32 v108, v108, v110
    s_nop 1
    v_add_f32_dpp v108, v108, v108 row_ror:8 row_mask:0xf bank_mask:0xf
    v_cvt_pk_bf16_f32 v108, v108, v108
    ds_write_b16 v235, v108
    s_lshl3_add_u32 s33, s26, s28
    s_lshl_b32 s33, s33, 5
    s_add_u32 s33, s33, s29
    s_mul_i32 s33, s33, 5120
    v_lshl_add_u32 v248, v1, 7, s33
    s_mov_b32 exec_hi, 0xff
    global_load_dword v0, v248, s[12:13]
    s_mov_b32 exec_hi, -1
    s_waitcnt lgkmcnt(0)
    s_barrier
    ds_read_b128 v[8:11], v241 offset:9408
    ds_read_b128 v[12:15], v241 offset:9344
    ds_read_b128 v[16:19], v241 offset:9280
    ds_read_b128 v[20:23], v241 offset:9216
    s_waitcnt lgkmcnt(3)
    v_mfma_f32_16x16x32_bf16 v[248:251], v[8:11], v[28:31], 0
    v_mfma_f32_16x16x32_bf16 v[252:255], v[8:11], v[44:47], 0
    s_waitcnt lgkmcnt(2)
    v_mfma_f32_16x16x32_bf16 v[248:251], v[12:15], v[32:35], v[248:251]
    v_mfma_f32_16x16x32_bf16 v[252:255], v[12:15], v[48:51], v[252:255]
    s_waitcnt lgkmcnt(1)
    v_mfma_f32_16x16x32_bf16 v[248:251], v[16:19], v[36:39], v[248:251]
    v_mfma_f32_16x16x32_bf16 v[252:255], v[16:19], v[52:55], v[252:255]
    s_waitcnt lgkmcnt(0)
    v_mfma_f32_16x16x32_bf16 v[248:251], v[20:23], v[40:43], v[248:251]
    v_mfma_f32_16x16x32_bf16 v[252:255], v[20:23], v[56:59], v[252:255]
    s_mov_b32 vcc_lo, 0xaaaaaaaa
    s_mov_b32 vcc_hi, 0xaaaaaaaa
    s_nop 4
    v_add_f32_dpp v250, v251, v250 quad_perm:[3,3,3,3] row_mask:0xf bank_mask:0xf
    v_add_f32_dpp v248, v249, v248 quad_perm:[1,1,1,1] row_mask:0xf bank_mask:0xf
    v_add_f32_dpp v254, v255, v254 quad_perm:[3,3,3,3] row_mask:0xf bank_mask:0xf
    v_add_f32_dpp v253, v252, v253 quad_perm:[0,0,0,0] row_mask:0xf bank_mask:0xf
    v_add_f32_dpp v248, v250, v248 quad_perm:[2,2,2,2] row_mask:0xf bank_mask:0xf
    s_nop 0
    v_add_f32_dpp v253, v254, v253 quad_perm:[2,2,2,2] row_mask:0xf bank_mask:0xf
    v_cndmask_b32 v24, v248, v253, vcc
    v_cvt_pk_bf16_f32 v24, v24, v24
    v_and_b32 v24, 0xffff0000, v24
    v_mul_f32 v24, s52, v24
    v_cvt_pk_bf16_f32 v24, v24, v24
    v_and_b32 v24, 0xffff0000, v24
    s_nop 1
    v_max_f32_dpp v26, v24, v24 quad_perm:[1,0,3,2] row_mask:0xf bank_mask:0xf
    s_nop 1
    v_max_f32_dpp v26, v26, v26 row_ror:4 row_mask:0xf bank_mask:0xf
    s_nop 1
    v_max_f32_dpp v26, v26, v26 row_ror:8 row_mask:0xf bank_mask:0xf
    v_mov_b32 v7, v26
    s_nop 1
    v_permlane32_swap_b32 v26, v7
    v_max_f32 v26, v26, v7
    v_mov_b32 v7, v26
    s_nop 1
    v_permlane16_swap_b32 v26, v7
    v_max_f32 v26, v26, v7
    v_sub_f32 v24, v24, v26
    v_mul_f32 v24, s51, v24
    v_exp_f32 v24, v24
    s_lshl_b32 s32, s26, 2
    v_mov_b32 v7, s32
    v_cvt_pk_bf16_f32 v27, v24, v24
    s_mov_b64 exec, 1
    ds_write_b32 v7, v26 offset:2304
    s_mov_b64 exec, -1
    v_and_b32 v6, 0xffff0000, v27
    v_and_b32_dpp v108, v27, v104 row_newbcast:0 row_mask:0xf bank_mask:0xf
    v_and_b32_dpp v109, v27, v105 row_newbcast:0 row_mask:0xf bank_mask:0xf
    v_and_b32_dpp v110, v27, v106 row_newbcast:0 row_mask:0xf bank_mask:0xf
    v_and_b32_dpp v111, v27, v107 row_newbcast:0 row_mask:0xf bank_mask:0xf
    v_add_f32_dpp v6, v6, v6 quad_perm:[1,0,3,2] row_mask:0xf bank_mask:0xf
    v_and_b32_dpp v112, v27, v104 row_newbcast:1 row_mask:0xf bank_mask:0xf
    v_and_b32_dpp v113, v27, v105 row_newbcast:1 row_mask:0xf bank_mask:0xf
    v_and_b32_dpp v114, v27, v106 row_newbcast:1 row_mask:0xf bank_mask:0xf
    v_and_b32_dpp v115, v27, v107 row_newbcast:1 row_mask:0xf bank_mask:0xf
    v_add_f32_dpp v6, v6, v6 row_ror:4 row_mask:0xf bank_mask:0xf
    v_and_b32_dpp v116, v27, v104 row_newbcast:4 row_mask:0xf bank_mask:0xf
    v_and_b32_dpp v117, v27, v105 row_newbcast:4 row_mask:0xf bank_mask:0xf
    v_and_b32_dpp v118, v27, v106 row_newbcast:4 row_mask:0xf bank_mask:0xf
    v_and_b32_dpp v119, v27, v107 row_newbcast:4 row_mask:0xf bank_mask:0xf
    v_add_f32_dpp v6, v6, v6 row_ror:8 row_mask:0xf bank_mask:0xf
    v_and_b32_dpp v120, v27, v104 row_newbcast:5 row_mask:0xf bank_mask:0xf
    v_and_b32_dpp v121, v27, v105 row_newbcast:5 row_mask:0xf bank_mask:0xf
    v_and_b32_dpp v122, v27, v106 row_newbcast:5 row_mask:0xf bank_mask:0xf
    v_and_b32_dpp v123, v27, v107 row_newbcast:5 row_mask:0xf bank_mask:0xf
    v_mov_b32 v7, v6
    v_and_b32_dpp v124, v27, v104 row_newbcast:8 row_mask:0xf bank_mask:0xf
    v_and_b32_dpp v125, v27, v105 row_newbcast:8 row_mask:0xf bank_mask:0xf
    v_and_b32_dpp v126, v27, v106 row_newbcast:8 row_mask:0xf bank_mask:0xf
    v_and_b32_dpp v127, v27, v107 row_newbcast:8 row_mask:0xf bank_mask:0xf
    v_permlane16_swap_b32 v6, v7
    v_and_b32_dpp v128, v27, v104 row_newbcast:9 row_mask:0xf bank_mask:0xf
    v_and_b32_dpp v129, v27, v105 row_newbcast:9 row_mask:0xf bank_mask:0xf
    v_and_b32_dpp v130, v27, v106 row_newbcast:9 row_mask:0xf bank_mask:0xf
    v_and_b32_dpp v131, v27, v107 row_newbcast:9 row_mask:0xf bank_mask:0xf
    v_add_f32 v6, v6, v7
    v_mov_b32 v7, v6
    v_and_b32_dpp v132, v27, v104 row_newbcast:12 row_mask:0xf bank_mask:0xf
    v_and_b32_dpp v133, v27, v105 row_newbcast:12 row_mask:0xf bank_mask:0xf
    v_and_b32_dpp v134, v27, v106 row_newbcast:12 row_mask:0xf bank_mask:0xf
    v_and_b32_dpp v135, v27, v107 row_newbcast:12 row_mask:0xf bank_mask:0xf
    v_permlane32_swap_b32 v6, v7
    v_and_b32_dpp v136, v27, v104 row_newbcast:13 row_mask:0xf bank_mask:0xf
    v_and_b32_dpp v137, v27, v105 row_newbcast:13 row_mask:0xf bank_mask:0xf
    v_and_b32_dpp v138, v27, v106 row_newbcast:13 row_mask:0xf bank_mask:0xf
    v_and_b32_dpp v139, v27, v107 row_newbcast:13 row_mask:0xf bank_mask:0xf
    v_add_f32 v6, v6, v7
    v_mfma_f32_16x16x32_bf16 v[248:251], v[108:111], v[60:63], 0
    v_mfma_f32_16x16x32_bf16 v[248:251], v[112:115], v[64:67], v[248:251]
    s_waitcnt vmcnt(8)
    v_mfma_f32_16x16x32_bf16 v[248:251], v[116:119], v[68:71], v[248:251]
    s_waitcnt vmcnt(7)
    v_mfma_f32_16x16x32_bf16 v[248:251], v[120:123], v[72:75], v[248:251]
    s_waitcnt vmcnt(5)
    v_mfma_f32_16x16x32_bf16 v[248:251], v[124:127], v[76:79], v[248:251]
    s_waitcnt vmcnt(4)
    v_mfma_f32_16x16x32_bf16 v[248:251], v[128:131], v[80:83], v[248:251]
    s_waitcnt vmcnt(3)
    v_mfma_f32_16x16x32_bf16 v[248:251], v[132:135], v[84:87], v[248:251]
    s_waitcnt vmcnt(2)
    v_mfma_f32_16x16x32_bf16 v[248:251], v[136:139], v[88:91], v[248:251]
    s_mov_b32 exec_hi, 1
    s_nop 6
    v_cndmask_b32 v248, v248, v6, s[46:47]
    ds_write_b128 v237, v[248:251]
    v_mov_b32 v7, 0
    s_waitcnt lgkmcnt(0)
    s_mov_b64 exec, s[92:93]
    s_barrier
    ds_read_b128 v[124:127], v7 offset:2304
    ds_read_b128 v[108:111], v238 offset:2560
    ds_read_b128 v[112:115], v238 offset:3088
    ds_read_b128 v[116:119], v238 offset:3616
    ds_read_b128 v[120:123], v238 offset:4144
    s_waitcnt lgkmcnt(4)
    v_max3_f32 v26, v124, v125, v126
    v_max_f32 v26, v26, v127
    v_sub_f32 v124, v124, v26
    v_sub_f32 v125, v125, v26
    v_sub_f32 v126, v126, v26
    v_sub_f32 v127, v127, v26
    v_mul_f32 v124, s51, v124
    v_mul_f32 v125, s51, v125
    v_mul_f32 v126, s51, v126
    v_mul_f32 v127, s51, v127
    v_exp_f32 v124, v124
    v_exp_f32 v125, v125
    v_exp_f32 v126, v126
    v_exp_f32 v127, v127
    v_cmp_lt_u32 vcc, 7, v1
    s_waitcnt lgkmcnt(0)
    v_pk_mul_f32 v[108:109], v[108:109], v[124:125] op_sel_hi:[1,0]
    v_pk_mul_f32 v[110:111], v[110:111], v[124:125] op_sel_hi:[1,0]
    v_pk_fma_f32 v[108:109], v[112:113], v[124:125], v[108:109] op_sel:[0,1,0]
    v_pk_fma_f32 v[110:111], v[114:115], v[124:125], v[110:111] op_sel:[0,1,0]
    v_pk_fma_f32 v[108:109], v[116:117], v[126:127], v[108:109] op_sel_hi:[1,0,1]
    v_pk_fma_f32 v[110:111], v[118:119], v[126:127], v[110:111] op_sel_hi:[1,0,1]
    v_pk_fma_f32 v[108:109], v[120:121], v[126:127], v[108:109] op_sel:[0,1,0]
    v_pk_fma_f32 v[110:111], v[122:123], v[126:127], v[110:111] op_sel:[0,1,0]
    v_cndmask_b32 v109, v109, v26, vcc
    v_perm_b32 v244, v108, v111, s40
    v_perm_b32 v245, v109, v111, s41
    v_perm_b32 v246, v110, v111, s42
    global_store_dwordx4 v239, v[244:247], s[100:101]
    s_mov_b64 exec, -1
    s_cmp_eq_u32 s99, 0
    s_cbranch_scc1 L_NHP
    s_mul_i32 s33, s26, 160
    v_add_u32 v248, s33, v1
    v_mul_u32_u24 v248, s90, v248
    s_lshl_b32 s90, s90, 6
    v_add_u32 v248, s91, v248
    v_add_u32 v249, s90, v248
    v_add_u32 v250, s90, v249
    global_load_dword v0, v248, s[54:55]
    s_cmp_eq_u32 s99, 2
    s_cselect_b64 exec, 0xffff, -1
    global_load_dword v0, v249, s[54:55]
    s_mov_b64 exec, -1
    s_cbranch_scc1 L_NHP
    s_mov_b32 exec_hi, 0
    global_load_dword v0, v250, s[54:55]
    s_mov_b32 exec_hi, -1
L_NHP:
    s_mov_b64 exec, s[58:59]
    global_load_lds_dwordx4 v240, s[54:55]
    s_add_u32 m0, m0, 1024
    v_add_u32 v240, s53, v240
    global_load_lds_dwordx4 v240, s[54:55]
    s_add_u32 m0, m0, 1024
    v_add_u32 v240, s53, v240
    global_load_lds_dwordx4 v240, s[54:55]
    s_add_u32 m0, m0, 1024
    v_add_u32 v240, s53, v240
    global_load_lds_dwordx4 v240, s[54:55]
    s_add_u32 m0, m0, s96
    v_add_u32 v240, s94, v240
    global_load_lds_dwordx4 v240, s[54:55]
    s_add_u32 m0, m0, s97
    v_add_u32 v240, s95, v240
    global_load_lds_dwordx4 v240, s[54:55]
    s_add_u32 m0, m0, 1024
    v_add_u32 v240, s53, v240
    global_load_lds_dwordx4 v240, s[54:55]
    s_add_u32 m0, m0, 1024
    v_add_u32 v240, s53, v240
    global_load_lds_dwordx4 v240, s[54:55]
    s_mov_b64 exec, -1
    v_bfe_u32 v248, v1, 2, 2
    v_lshl_add_u32 v248, v4, 3, v248
    v_and_b32 v249, 3, v1
    v_lshlrev_b32 v249, 3, v249
    s_mul_i32 s32, s26, 10240
    s_add_u32 s33, s32, 13312
    v_lshl_add_u32 v220, v248, 6, s33
    v_add_u32 v220, v249, v220
    s_movk_i32 s48, 32767
    s_cmp_lg_u32 s50, 0
    s_cbranch_scc1 L_NWO
    s_lshl3_add_u32 s32, s26, s28
    s_mul_i32 s32, s32, 5120
    s_add_u32 s32, s32, 262144
    v_lshrrev_b32 v248, 5, v1
    v_and_b32 v249, 31, v1
    s_movk_i32 s33, 2560
    v_mul_u32_u24 v221, s33, v248
    v_lshl_add_u32 v221, v249, 4, v221
    v_add_u32 v221, s32, v221
    v_and_b32 v250, 7, v1
    v_lshlrev_b32 v251, 2, v248
    v_xor_b32 v250, v250, v251
    s_movk_i32 s33, 640
    v_mul_u32_u24 v222, s33, v250
    v_add_u32 v222, s32, v222
    global_load_dwordx4 v[124:127], v222, s[100:101] offset:512 nt
    global_load_dwordx4 v[108:111], v221, s[100:101] offset:0 nt
    global_load_dwordx4 v[112:115], v221, s[100:101] offset:640 nt
    global_load_dwordx4 v[116:119], v221, s[100:101] offset:1280 nt
    global_load_dwordx4 v[120:123], v221, s[100:101] offset:1920 nt
    s_lshl_b32 s33, s26, 8
    s_add_u32 s33, s33, 4864
    v_lshl_add_u32 v223, v249, 3, s33
    v_add_u32 v223, v251, v223
    v_add_u32 v224, s33, v236
    s_lshl_b32 s33, s26, 7
    v_add_u32 v225, s33, v236
    s_mul_i32 s33, s28, 2560
    s_lshl_b32 s34, s49, 7
    s_add_u32 s33, s33, s34
    s_add_u32 s33, s33, 720896
    v_and_b32 v232, 7, v1
    v_lshlrev_b32 v232, 4, v232
    v_lshrrev_b32 v248, 3, v1
    s_movk_i32 s34, 20480
    v_mad_u32_u24 v226, v248, s34, v232
    v_add_u32 v226, s33, v226
    v_and_b32 v248, 1, v4
    v_mul_u32_u24 v248, 56, v248
    v_lshrrev_b32 v250, 1, v4
    v_mul_u32_u24 v250, 12, v250
    v_sub_u32 v248, v248, v250
    v_lshl_add_u32 v220, v248, 6, v220
    s_waitcnt vmcnt(5)
    ds_read_b64_tr_b16 v[140:141], v220 offset:0
    ds_read_b64_tr_b16 v[142:143], v220 offset:512
    ds_read_b64_tr_b16 v[144:145], v220 offset:32
    ds_read_b64_tr_b16 v[146:147], v220 offset:544
    ds_read_b64_tr_b16 v[148:149], v220 offset:1024
    ds_read_b64_tr_b16 v[150:151], v220 offset:1536
    ds_read_b64_tr_b16 v[152:153], v220 offset:1056
    ds_read_b64_tr_b16 v[154:155], v220 offset:1568
    ds_read_b64_tr_b16 v[156:157], v220 offset:2048
    ds_read_b64_tr_b16 v[158:159], v220 offset:2560
    ds_read_b64_tr_b16 v[160:161], v220 offset:2080
    ds_read_b64_tr_b16 v[162:163], v220 offset:2592
    ds_read_b64_tr_b16 v[164:165], v220 offset:3072
    ds_read_b64_tr_b16 v[166:167], v220 offset:3584
    ds_read_b64_tr_b16 v[168:169], v220 offset:3104
    ds_read_b64_tr_b16 v[170:171], v220 offset:3616
    s_branch L_OCHK
L_OPOLL:
    s_sub_u32 s48, s48, 1
    s_cbranch_scc1 L_OOK
    s_and_b32 s33, s48, 63
    s_cbranch_scc1 L_OFAST
    s_mov_b64 exec, s[92:93]
    global_store_dwordx4 v239, v[244:247], s[24:25] sc1
    s_mov_b64 exec, -1
    global_load_dwordx4 v[124:127], v222, s[24:25] offset:512 sc1
    global_load_dwordx4 v[108:111], v221, s[24:25] offset:0 sc1
    global_load_dwordx4 v[112:115], v221, s[24:25] offset:640 sc1
    global_load_dwordx4 v[116:119], v221, s[24:25] offset:1280 sc1
    global_load_dwordx4 v[120:123], v221, s[24:25] offset:1920 sc1
    s_branch L_OCHK
L_OFAST:
    global_load_dwordx4 v[124:127], v222, s[100:101] offset:512 nt
    global_load_dwordx4 v[108:111], v221, s[100:101] offset:0 nt
    global_load_dwordx4 v[112:115], v221, s[100:101] offset:640 nt
    global_load_dwordx4 v[116:119], v221, s[100:101] offset:1280 nt
    global_load_dwordx4 v[120:123], v221, s[100:101] offset:1920 nt
L_OCHK:
    s_waitcnt vmcnt(0)
    v_xor_b32 v5, s27, v127
    v_bitop3_b32 v5, v5, v111, s27 bitop3:0xf6
    v_bitop3_b32 v5, v5, v115, s27 bitop3:0xf6
    v_bitop3_b32 v5, v5, v119, s27 bitop3:0xf6
    v_bitop3_b32 v5, v5, v123, s27 bitop3:0xf6
    v_cmp_ne_u32 vcc, 0, v5
    s_cbranch_vccnz L_OPOLL
L_OOK:
    v_max_f32_dpp v26, v125, v125 row_half_mirror row_mask:0xf bank_mask:0xf
    v_perm_b32 v128, v109, v108, s43
    v_lshl_or_b32 v128, v110, 24, v128
    v_max_f32_dpp v26, v26, v26 quad_perm:[1,0,3,2] row_mask:0xf bank_mask:0xf
    v_perm_b32 v129, v113, v112, s43
    v_lshl_or_b32 v129, v114, 24, v129
    v_max_f32_dpp v26, v26, v26 quad_perm:[2,3,0,1] row_mask:0xf bank_mask:0xf
    v_sub_f32 v24, v125, v26
    v_mul_f32 v24, s51, v24
    v_exp_f32 v24, v24
    v_perm_b32 v130, v117, v116, s43
    v_lshl_or_b32 v130, v118, 24, v130
    v_perm_b32 v131, v121, v120, s43
    v_lshl_or_b32 v131, v122, 24, v131
    v_mul_f32 v25, v24, v124
    v_mul_f32_dpp v248, v24, v108 row_newbcast:0 row_mask:0xf bank_mask:0xf
    v_mul_f32_dpp v249, v24, v109 row_newbcast:0 row_mask:0xf bank_mask:0xf
    v_mul_f32_dpp v250, v24, v110 row_newbcast:0 row_mask:0xf bank_mask:0xf
    v_mul_f32_dpp v251, v24, v128 row_newbcast:0 row_mask:0xf bank_mask:0xf
    v_add_f32_dpp v25, v25, v25 row_half_mirror row_mask:0xf bank_mask:0xf
    v_fmac_f32_dpp v248, v24, v112 row_newbcast:1 row_mask:0xf bank_mask:0xf
    v_fmac_f32_dpp v249, v24, v113 row_newbcast:1 row_mask:0xf bank_mask:0xf
    v_fmac_f32_dpp v250, v24, v114 row_newbcast:1 row_mask:0xf bank_mask:0xf
    v_fmac_f32_dpp v251, v24, v129 row_newbcast:1 row_mask:0xf bank_mask:0xf
    v_add_f32_dpp v25, v25, v25 quad_perm:[1,0,3,2] row_mask:0xf bank_mask:0xf
    v_fmac_f32_dpp v248, v24, v116 row_newbcast:2 row_mask:0xf bank_mask:0xf
    v_fmac_f32_dpp v249, v24, v117 row_newbcast:2 row_mask:0xf bank_mask:0xf
    v_fmac_f32_dpp v250, v24, v118 row_newbcast:2 row_mask:0xf bank_mask:0xf
    v_fmac_f32_dpp v251, v24, v130 row_newbcast:2 row_mask:0xf bank_mask:0xf
    v_add_f32_dpp v25, v25, v25 quad_perm:[2,3,0,1] row_mask:0xf bank_mask:0xf
    v_fmac_f32_dpp v248, v24, v120 row_newbcast:3 row_mask:0xf bank_mask:0xf
    v_fmac_f32_dpp v249, v24, v121 row_newbcast:3 row_mask:0xf bank_mask:0xf
    v_fmac_f32_dpp v250, v24, v122 row_newbcast:3 row_mask:0xf bank_mask:0xf
    v_fmac_f32_dpp v251, v24, v131 row_newbcast:3 row_mask:0xf bank_mask:0xf
    v_rcp_f32 v25, v25
    v_permlane32_swap_b32 v248, v250
    v_permlane32_swap_b32 v249, v251
    v_pk_add_f32 v[248:249], v[248:249], v[250:251]
    v_mul_f32 v248, v248, v25
    v_mul_f32 v249, v249, v25
    v_cvt_pk_bf16_f32 v24, v248, v249
    s_waitcnt lgkmcnt(0)
    s_nop 0
    v_mov_b32_dpp v28, v24 row_newbcast:0 row_mask:0xf bank_mask:0xf
    v_mov_b32_dpp v29, v24 row_newbcast:1 row_mask:0xf bank_mask:0xf
    v_mov_b32_dpp v30, v24 row_newbcast:2 row_mask:0xf bank_mask:0xf
    v_mov_b32_dpp v31, v24 row_newbcast:3 row_mask:0xf bank_mask:0xf
    v_mov_b32_dpp v32, v24 row_newbcast:4 row_mask:0xf bank_mask:0xf
    v_mov_b32_dpp v33, v24 row_newbcast:5 row_mask:0xf bank_mask:0xf
    v_mov_b32_dpp v34, v24 row_newbcast:6 row_mask:0xf bank_mask:0xf
    v_mov_b32_dpp v35, v24 row_newbcast:7 row_mask:0xf bank_mask:0xf
    v_mfma_f32_16x16x32_bf16 v[248:251], v[140:143], v[28:31], 0
    v_mfma_f32_16x16x32_bf16 v[252:255], v[144:147], v[28:31], 0
    v_mov_b32_dpp v36, v24 row_newbcast:8 row_mask:0xf bank_mask:0xf
    v_mov_b32_dpp v37, v24 row_newbcast:9 row_mask:0xf bank_mask:0xf
    v_mov_b32_dpp v38, v24 row_newbcast:10 row_mask:0xf bank_mask:0xf
    v_mov_b32_dpp v39, v24 row_newbcast:11 row_mask:0xf bank_mask:0xf
    v_mfma_f32_16x16x32_bf16 v[248:251], v[148:151], v[32:35], v[248:251]
    v_mfma_f32_16x16x32_bf16 v[252:255], v[152:155], v[32:35], v[252:255]
    v_mov_b32_dpp v40, v24 row_newbcast:12 row_mask:0xf bank_mask:0xf
    v_mov_b32_dpp v41, v24 row_newbcast:13 row_mask:0xf bank_mask:0xf
    v_mov_b32_dpp v42, v24 row_newbcast:14 row_mask:0xf bank_mask:0xf
    v_mov_b32_dpp v43, v24 row_newbcast:15 row_mask:0xf bank_mask:0xf
    v_mfma_f32_16x16x32_bf16 v[248:251], v[156:159], v[36:39], v[248:251]
    v_mfma_f32_16x16x32_bf16 v[252:255], v[160:163], v[36:39], v[252:255]
    v_mfma_f32_16x16x32_bf16 v[248:251], v[164:167], v[40:43], v[248:251]
    v_mfma_f32_16x16x32_bf16 v[252:255], v[168:171], v[40:43], v[252:255]
    s_mov_b32 exec_lo, 0x00010001
    s_mov_b32 exec_hi, 0x00010001
    s_nop 4
    ds_write_b128 v225, v[248:251] offset:5888
    ds_write_b128 v225, v[252:255] offset:5952
    s_cmp_lg_u32 s26, 0
    s_mov_b64 exec, s[92:93]
    global_store_dwordx4 v239, v[244:247], s[24:25] sc1
    s_mov_b64 exec, -1
    s_waitcnt lgkmcnt(0)
    s_mov_b64 exec, -1
    s_barrier
    s_cbranch_scc1 L_DONE
    ds_read_b128 v[28:31], v232 offset:5888
    ds_read_b128 v[32:35], v232 offset:6016
    ds_read_b128 v[36:39], v232 offset:6144
    ds_read_b128 v[40:43], v232 offset:6272
    s_waitcnt lgkmcnt(0)
    v_pk_add_f32 v[28:29], v[28:29], v[32:33]
    v_pk_add_f32 v[30:31], v[30:31], v[34:35]
    v_pk_add_f32 v[36:37], v[36:37], v[40:41]
    v_pk_add_f32 v[38:39], v[38:39], v[42:43]
    v_pk_add_f32 v[28:29], v[28:29], v[36:37]
    v_pk_add_f32 v[30:31], v[30:31], v[38:39]
    v_perm_b32 v244, v28, v31, s40
    v_perm_b32 v245, v29, v31, s41
    v_perm_b32 v246, v30, v31, s42
    global_store_dwordx4 v226, v[244:247], s[24:25] sc1
    s_branch L_DONE
L_NWO:
    s_mov_b64 exec, s[58:59]
    s_add_u32 m0, m0, 1024
    v_add_u32 v240, s53, v240
    global_load_lds_dwordx4 v240, s[54:55]
    s_add_u32 m0, m0, 1024
    v_add_u32 v240, s53, v240
    global_load_lds_dwordx4 v240, s[54:55]
    s_mov_b64 exec, -1
    s_mov_b64 exec, s[92:93]
    global_store_dwordx4 v239, v[244:247], s[24:25] sc1
    s_mov_b64 exec, -1
    s_cmp_eq_u32 s50, 3
    s_cbranch_scc1 L_DONE
    s_cmp_eq_u32 s50, 2
    s_cbranch_scc1 L_FIN
    s_mov_b32 s90, 0x3ff03ff
    s_mov_b32 s91, s90
    v_mad_u32_u24 v224, v4, 10, v3
    s_mul_i32 s33, s26, 320
    v_lshl_add_u32 v224, v224, 3, s33
    s_mov_b64 exec, s[90:91]
    global_load_dwordx2 v[96:97], v224, s[4:5]
    s_mov_b64 exec, -1
    s_mul_i32 s34, s28, 20480
    s_add_u32 s34, s34, 723456
    v_lshl_add_u32 v221, v224, 1, s34
    v_add_u32 v222, 7680, v221
    v_add_u32 v223, 15360, v221
    s_mul_i32 s34, s49, 40960
    s_add_u32 s34, s34, s33
    s_add_u32 m0, s32, 54272
    s_movk_i32 s35, 3277
    s_movk_i32 s36, 960
    v_lshl_add_u32 v250, v1, 4, s34
    v_mul_u32_u24 v251, s35, v1
    v_lshrrev_b32 v252, 16, v251
    v_mad_u32_u24 v253, v252, s36, v250
    global_load_lds_dwordx4 v253, s[18:19]
    s_add_u32 m0, m0, 1024
    v_add_u32 v250, 1024, v250
    v_add_u32 v251, 209728, v251
    v_lshrrev_b32 v252, 16, v251
    v_mad_u32_u24 v254, v252, s36, v250
    global_load_lds_dwordx4 v254, s[18:19]
    s_add_u32 m0, m0, 1024
    v_add_u32 v250, 1024, v250
    v_add_u32 v251, 209728, v251
    v_lshrrev_b32 v252, 16, v251
    v_mad_u32_u24 v253, v252, s36, v250
    global_load_lds_dwordx4 v253, s[18:19]
    s_add_u32 m0, m0, 1024
    v_add_u32 v250, 1024, v250
    v_add_u32 v251, 209728, v251
    v_lshrrev_b32 v252, 16, v251
    v_mad_u32_u24 v254, v252, s36, v250
    global_load_lds_dwordx4 v254, s[18:19]
    s_add_u32 m0, m0, 1024
    v_add_u32 v250, 1024, v250
    v_add_u32 v251, 209728, v251
    v_lshrrev_b32 v252, 16, v251
    v_mad_u32_u24 v253, v252, s36, v250
    global_load_lds_dwordx4 v253, s[18:19]
    s_add_u32 m0, m0, 1024
    v_add_u32 v250, 1024, v250
    v_add_u32 v251, 209728, v251
    v_lshrrev_b32 v252, 16, v251
    v_mad_u32_u24 v254, v252, s36, v250
    global_load_lds_dwordx4 v254, s[18:19]
    s_add_u32 m0, m0, 1024
    v_add_u32 v250, 1024, v250
    v_add_u32 v251, 209728, v251
    v_lshrrev_b32 v252, 16, v251
    v_mad_u32_u24 v253, v252, s36, v250
    global_load_lds_dwordx4 v253, s[18:19]
    s_add_u32 m0, m0, 1024
    v_add_u32 v250, 1024, v250
    v_add_u32 v251, 209728, v251
    v_lshrrev_b32 v252, 16, v251
    v_mad_u32_u24 v254, v252, s36, v250
    global_load_lds_dwordx4 v254, s[18:19]
    s_add_u32 m0, m0, 1024
    v_add_u32 v250, 1024, v250
    v_add_u32 v251, 209728, v251
    v_lshrrev_b32 v252, 16, v251
    v_mad_u32_u24 v253, v252, s36, v250
    global_load_lds_dwordx4 v253, s[18:19]
    s_add_u32 m0, m0, 1024
    v_add_u32 v250, 1024, v250
    v_add_u32 v251, 209728, v251
    v_lshrrev_b32 v252, 16, v251
    v_mad_u32_u24 v254, v252, s36, v250
    global_load_lds_dwordx4 v254, s[18:19]
    s_mov_b64 exec, s[90:91]
    global_load_dwordx4 v[28:31], v221, s[24:25] offset:-2560 sc1
    global_load_dwordx4 v[32:35], v221, s[24:25] offset:0 sc1
    global_load_dwordx4 v[36:39], v221, s[24:25] offset:2560 sc1
    global_load_dwordx4 v[40:43], v222, s[24:25] offset:-2560 sc1
    global_load_dwordx4 v[44:47], v222, s[24:25] offset:0 sc1
    global_load_dwordx4 v[48:51], v222, s[24:25] offset:2560 sc1
    global_load_dwordx4 v[52:55], v223, s[24:25] offset:-2560 sc1
    global_load_dwordx4 v[56:59], v223, s[24:25] offset:0 sc1
    s_mov_b64 exec, -1
    s_movk_i32 s35, 320
    s_add_u32 s36, s32, 54272
    v_mul_u32_u24 v225, s35, v248
    v_add3_u32 v225, v225, v249, s36

    v_add_u32 v226, s33, v236
    v_and_b32 v248, 63, v1
    s_lshl_b32 s35, s26, 2
    v_lshl_add_u32 v227, v248, 4, s35
    v_and_b32 v248, 7, v1
    v_lshl_add_u32 v248, v4, 3, v248
    v_lshlrev_b32 v228, 4, v248
    s_lshl_b32 s35, s49, 7
    s_mul_i32 s36, s26, 40960
    s_add_u32 s35, s35, s36
    s_add_u32 s35, s35, 524288
    v_and_b32 v248, 7, v1
    v_lshl_add_u32 v229, v248, 4, s35
    v_lshrrev_b32 v248, 3, v1
    v_lshl_add_u32 v229, v248, 13, v229
    v_lshrrev_b32 v248, 2, v3
    v_cmp_eq_u32 vcc, 0, v248
    s_nop 1
    v_cndmask_b32 v231, 0, -1, vcc
    v_cmp_eq_u32 vcc, 1, v248
    s_nop 1
    v_cndmask_b32 v232, 0, -1, vcc
    v_cmp_eq_u32 vcc, 2, v248
    s_nop 1
    v_cndmask_b32 v233, 0, -1, vcc
    s_mov_b32 s34, 0x3f803f80
    s_mov_b32 s35, s34
    v_mov_b64 v[120:121], s[34:35]
    v_mov_b64 v[122:123], s[34:35]
    v_mov_b64 v[124:125], s[34:35]
    v_mov_b64 v[126:127], s[34:35]
    v_mov_b64 v[128:129], s[34:35]
    v_mov_b64 v[130:131], s[34:35]
    v_mov_b64 v[132:133], s[34:35]
    v_mov_b64 v[134:135], s[34:35]
    v_mov_b64 v[136:137], s[34:35]
    v_mov_b64 v[138:139], s[34:35]
    v_mov_b32 v24, 0
    v_mov_b32 v25, 0
    s_lshl_b32 s35, s26, 2
    v_mov_b32 v7, s35
    v_mov_b32 v6, 0
    v_mov_b64 v[108:109], 0
    v_lshl_add_u32 v220, v4, 11, v220
    v_add_u32 v7, v7, v236
    s_waitcnt vmcnt(18)
    ds_read_b64_tr_b16 v[140:141], v220 offset:0
    ds_read_b64_tr_b16 v[142:143], v220 offset:256
    ds_read_b64_tr_b16 v[144:145], v220 offset:32
    ds_read_b64_tr_b16 v[146:147], v220 offset:288
    ds_read_b64_tr_b16 v[148:149], v220 offset:512
    ds_read_b64_tr_b16 v[150:151], v220 offset:768
    ds_read_b64_tr_b16 v[152:153], v220 offset:544
    ds_read_b64_tr_b16 v[154:155], v220 offset:800
    ds_read_b64_tr_b16 v[156:157], v220 offset:1024
    ds_read_b64_tr_b16 v[158:159], v220 offset:1280
    ds_read_b64_tr_b16 v[160:161], v220 offset:1056
    ds_read_b64_tr_b16 v[162:163], v220 offset:1312
    ds_read_b64_tr_b16 v[164:165], v220 offset:1536
    ds_read_b64_tr_b16 v[166:167], v220 offset:1792
    ds_read_b64_tr_b16 v[168:169], v220 offset:1568
    ds_read_b64_tr_b16 v[170:171], v220 offset:1824
    ds_read_b64_tr_b16 v[172:173], v220 offset:2048
    ds_read_b64_tr_b16 v[174:175], v220 offset:2304
    ds_read_b64_tr_b16 v[176:177], v220 offset:2080
    ds_read_b64_tr_b16 v[178:179], v220 offset:2336
    v_lshlrev_b32 v92, 16, v96
    v_and_b32 v93, 0xffff0000, v96
    v_lshlrev_b32 v94, 16, v97
    v_and_b32 v95, 0xffff0000, v97
    s_waitcnt vmcnt(8)
    ds_read_b64_tr_b16 v[180:181], v225 offset:0
    ds_read_b64_tr_b16 v[182:183], v225 offset:1280
    ds_read_b64_tr_b16 v[184:185], v225 offset:32
    ds_read_b64_tr_b16 v[186:187], v225 offset:1312
    ds_read_b64_tr_b16 v[188:189], v225 offset:64
    ds_read_b64_tr_b16 v[190:191], v225 offset:1344
    ds_read_b64_tr_b16 v[192:193], v225 offset:96
    ds_read_b64_tr_b16 v[194:195], v225 offset:1376
    ds_read_b64_tr_b16 v[196:197], v225 offset:128
    ds_read_b64_tr_b16 v[198:199], v225 offset:1408
    ds_read_b64_tr_b16 v[200:201], v225 offset:160
    ds_read_b64_tr_b16 v[202:203], v225 offset:1440
    ds_read_b64_tr_b16 v[204:205], v225 offset:192
    ds_read_b64_tr_b16 v[206:207], v225 offset:1472
    ds_read_b64_tr_b16 v[208:209], v225 offset:224
    ds_read_b64_tr_b16 v[210:211], v225 offset:1504
    ds_read_b64_tr_b16 v[212:213], v225 offset:256
    ds_read_b64_tr_b16 v[214:215], v225 offset:1536
    ds_read_b64_tr_b16 v[216:217], v225 offset:288
    ds_read_b64_tr_b16 v[218:219], v225 offset:1568
    s_mov_b64 exec, s[90:91]
    s_branch L_YCHKM
L_YPOLLM:
    s_mov_b64 exec, s[4:5]
    global_load_dwordx4 v[28:31], v221, s[24:25] offset:-2560 sc1
    s_mov_b64 exec, s[6:7]
    global_load_dwordx4 v[32:35], v221, s[24:25] offset:0 sc1
    s_mov_b64 exec, s[8:9]
    global_load_dwordx4 v[36:39], v221, s[24:25] offset:2560 sc1
    s_mov_b64 exec, s[10:11]
    global_load_dwordx4 v[40:43], v222, s[24:25] offset:-2560 sc1
    s_mov_b64 exec, s[12:13]
    global_load_dwordx4 v[44:47], v222, s[24:25] offset:0 sc1
    s_mov_b64 exec, s[14:15]
    global_load_dwordx4 v[48:51], v222, s[24:25] offset:2560 sc1
    s_mov_b64 exec, s[16:17]
    global_load_dwordx4 v[52:55], v223, s[24:25] offset:-2560 sc1
    s_mov_b64 exec, s[18:19]
    global_load_dwordx4 v[56:59], v223, s[24:25] offset:0 sc1
    s_mov_b64 exec, s[90:91]
    s_sub_u32 s48, s48, 1
    s_cbranch_scc1 L_YOKM
L_YCHKM:
    s_waitcnt vmcnt(7)
    v_cmp_ne_u32 s[4:5], s27, v31
    v_perm_b32 v111, v29, v28, s43
    v_lshl_or_b32 v111, v30, 24, v111
    s_waitcnt vmcnt(6)
    v_cmp_ne_u32 s[6:7], s27, v35
    v_perm_b32 v113, v33, v32, s43
    v_pk_add_f32 v[108:109], v[28:29], v[32:33]
    v_lshl_or_b32 v113, v34, 24, v113
    v_add_f32 v110, v30, v34
    v_add_f32 v111, v111, v113
    s_or_b64 vcc, s[4:5], s[6:7]
    s_waitcnt vmcnt(5)
    v_cmp_ne_u32 s[8:9], s27, v39
    v_perm_b32 v112, v37, v36, s43
    v_pk_add_f32 v[108:109], v[108:109], v[36:37]
    v_lshl_or_b32 v112, v38, 24, v112
    v_add_f32 v110, v110, v38
    v_add_f32 v111, v111, v112
    s_or_b64 vcc, vcc, s[8:9]
    s_waitcnt vmcnt(4)
    v_cmp_ne_u32 s[10:11], s27, v43
    v_perm_b32 v113, v41, v40, s43
    v_pk_add_f32 v[108:109], v[108:109], v[40:41]
    v_lshl_or_b32 v113, v42, 24, v113
    v_add_f32 v110, v110, v42
    v_add_f32 v111, v111, v113
    s_or_b64 vcc, vcc, s[10:11]
    s_waitcnt vmcnt(3)
    v_cmp_ne_u32 s[12:13], s27, v47
    v_perm_b32 v112, v45, v44, s43
    v_pk_add_f32 v[108:109], v[108:109], v[44:45]
    v_lshl_or_b32 v112, v46, 24, v112
    v_add_f32 v110, v110, v46
    v_add_f32 v111, v111, v112
    s_or_b64 vcc, vcc, s[12:13]
    s_waitcnt vmcnt(2)
    v_cmp_ne_u32 s[14:15], s27, v51
    v_perm_b32 v113, v49, v48, s43
    v_pk_add_f32 v[108:109], v[108:109], v[48:49]
    v_lshl_or_b32 v113, v50, 24, v113
    v_add_f32 v110, v110, v50
    v_add_f32 v111, v111, v113
    s_or_b64 vcc, vcc, s[14:15]
    s_waitcnt vmcnt(1)
    v_cmp_ne_u32 s[16:17], s27, v55
    v_perm_b32 v112, v53, v52, s43
    v_pk_add_f32 v[108:109], v[108:109], v[52:53]
    v_lshl_or_b32 v112, v54, 24, v112
    v_add_f32 v110, v110, v54
    v_add_f32 v111, v111, v112
    s_or_b64 vcc, vcc, s[16:17]
    s_waitcnt vmcnt(0)
    v_cmp_ne_u32 s[18:19], s27, v59
    v_perm_b32 v113, v57, v56, s43
    v_pk_add_f32 v[108:109], v[108:109], v[56:57]
    v_lshl_or_b32 v113, v58, 24, v113
    v_add_f32 v110, v110, v58
    v_add_f32 v111, v111, v113
    s_or_b64 vcc, vcc, s[18:19]
    s_cbranch_scc1 L_YPOLLM
L_YOKM:
    v_cvt_pk_bf16_f32 v112, v108, v109
    v_cvt_pk_bf16_f32 v113, v110, v111
    v_lshlrev_b32 v108, 16, v112
    v_and_b32 v109, 0xffff0000, v112
    v_lshlrev_b32 v110, 16, v113
    v_and_b32 v111, 0xffff0000, v113
    v_pk_add_f32 v[108:109], v[108:109], v[92:93]
    v_pk_add_f32 v[110:111], v[110:111], v[94:95]
    v_cvt_pk_bf16_f32 v108, v108, v109
    v_cvt_pk_bf16_f32 v109, v110, v111
    s_mov_b64 exec, -1
    v_lshlrev_b32 v112, 16, v108
    v_and_b32 v113, 0xffff0000, v108
    v_lshlrev_b32 v114, 16, v109
    v_and_b32 v115, 0xffff0000, v109
    v_pk_mul_f32 v[116:117], v[112:113], v[112:113]
    v_pk_add_f32 v[112:113], v[112:113], v[114:115]
    v_pk_fma_f32 v[116:117], v[114:115], v[114:115], v[116:117]
    v_add_f32 v24, v112, v113
    v_add_f32 v25, v116, v117
    s_waitcnt lgkmcnt(0)
    v_mov_b32_dpp v120, v108 row_newbcast:0 row_mask:0xf bank_mask:0x3
    v_mov_b32_dpp v121, v109 row_newbcast:0 row_mask:0xf bank_mask:0x3
    v_mov_b32_dpp v122, v108 row_newbcast:1 row_mask:0xf bank_mask:0x3
    v_mov_b32_dpp v123, v109 row_newbcast:1 row_mask:0xf bank_mask:0x3
    v_add_f32_dpp v24, v24, v24 row_ror:8 row_mask:0xf bank_mask:0xf
    v_add_f32_dpp v25, v25, v25 row_ror:8 row_mask:0xf bank_mask:0xf
    v_mfma_f32_16x16x32_bf16 v[248:251], v[120:123], v[140:143], 0
    v_mfma_f32_16x16x32_bf16 v[252:255], v[120:123], v[144:147], 0
    v_mov_b32_dpp v124, v108 row_newbcast:2 row_mask:0xf bank_mask:0x3
    v_mov_b32_dpp v125, v109 row_newbcast:2 row_mask:0xf bank_mask:0x3
    v_mov_b32_dpp v126, v108 row_newbcast:3 row_mask:0xf bank_mask:0x3
    v_mov_b32_dpp v127, v109 row_newbcast:3 row_mask:0xf bank_mask:0x3
    v_add_f32_dpp v24, v24, v24 row_ror:4 row_mask:0xf bank_mask:0xf
    v_add_f32_dpp v25, v25, v25 row_ror:4 row_mask:0xf bank_mask:0xf
    v_mfma_f32_16x16x32_bf16 v[248:251], v[124:127], v[148:151], v[248:251]
    v_mfma_f32_16x16x32_bf16 v[252:255], v[124:127], v[152:155], v[252:255]
    v_mov_b32_dpp v128, v108 row_newbcast:4 row_mask:0xf bank_mask:0x3
    v_mov_b32_dpp v129, v109 row_newbcast:4 row_mask:0xf bank_mask:0x3
    v_mov_b32_dpp v130, v108 row_newbcast:5 row_mask:0xf bank_mask:0x3
    v_mov_b32_dpp v131, v109 row_newbcast:5 row_mask:0xf bank_mask:0x3
    v_add_f32_dpp v24, v24, v24 row_ror:2 row_mask:0xf bank_mask:0xf
    v_add_f32_dpp v25, v25, v25 row_ror:2 row_mask:0xf bank_mask:0xf
    v_mfma_f32_16x16x32_bf16 v[248:251], v[128:131], v[156:159], v[248:251]
    v_mfma_f32_16x16x32_bf16 v[252:255], v[128:131], v[160:163], v[252:255]
    v_mov_b32_dpp v132, v108 row_newbcast:6 row_mask:0xf bank_mask:0x3
    v_mov_b32_dpp v133, v109 row_newbcast:6 row_mask:0xf bank_mask:0x3
    v_mov_b32_dpp v134, v108 row_newbcast:7 row_mask:0xf bank_mask:0x3
    v_mov_b32_dpp v135, v109 row_newbcast:7 row_mask:0xf bank_mask:0x3
    v_add_f32_dpp v24, v24, v24 row_ror:1 row_mask:0xf bank_mask:0xf
    v_add_f32_dpp v25, v25, v25 row_ror:1 row_mask:0xf bank_mask:0xf
    v_mfma_f32_16x16x32_bf16 v[248:251], v[132:135], v[164:167], v[248:251]
    v_mfma_f32_16x16x32_bf16 v[252:255], v[132:135], v[168:171], v[252:255]
    v_mov_b32_dpp v136, v108 row_newbcast:8 row_mask:0xf bank_mask:0x3
    v_mov_b32_dpp v137, v109 row_newbcast:8 row_mask:0xf bank_mask:0x3
    v_mov_b32_dpp v138, v108 row_newbcast:9 row_mask:0xf bank_mask:0x3
    v_mov_b32_dpp v139, v109 row_newbcast:9 row_mask:0xf bank_mask:0x3
    v_permlane16_swap_b32 v24, v25
    v_add_f32 v24, v24, v25
    v_mfma_f32_16x16x32_bf16 v[248:251], v[136:139], v[172:175], v[248:251]
    v_mfma_f32_16x16x32_bf16 v[252:255], v[136:139], v[176:179], v[252:255]
    v_mov_b32 v25, v24
    s_nop 1
    v_permlane32_swap_b32 v24, v25
    v_add_f32 v24, v24, v25
    s_mov_b64 exec, 0x10001
    ds_write_b32 v7, v24 offset:8704
    s_mov_b64 exec, -1
    v_cndmask_b32 v248, v248, v252, s[44:45]
    ds_write_b32 v227, v248 offset:7680
    s_mov_b64 exec, -1
    s_waitcnt lgkmcnt(0)
    s_barrier

    ds_read_b128 v[108:111], v6 offset:8704
    ds_read_b128 v[248:251], v228 offset:8192
    ds_read_b128 v[116:119], v228 offset:7680
    ds_read_b128 v[112:115], v6 offset:8720
    s_waitcnt lgkmcnt(3)
    v_pk_add_f32 v[108:109], v[108:109], v[110:111]
    s_waitcnt lgkmcnt(2)
    v_pk_add_f32 v[248:249], v[248:249], v[250:251]
    v_add_f32 v108, v108, v109
    s_waitcnt lgkmcnt(1)
    v_pk_add_f32 v[116:117], v[116:117], v[118:119]
    v_mul_f32 v108, 986500301, v108
    v_add_f32 v230, v248, v249
    v_cvt_pk_bf16_f32 v109, v108, v108
    v_add_f32 v116, v116, v117
    v_and_b32 v109, 0xffff0000, v109
    s_waitcnt lgkmcnt(0)
    v_pk_add_f32 v[112:113], v[112:113], v[114:115]
    v_fma_f32 v116, -v109, v230, v116
    v_add_f32 v112, v112, v113
    v_max_f32 v116, 0, v116
    v_mul_f32 v112, 986500301, v112
    v_fma_f32 v112, -v108, v108, v112
    v_mov_b32_dpp v117, v116 quad_perm:[1,1,3,3] row_mask:0xf bank_mask:0xf
    v_max_f32 v112, 0, v112
    v_cvt_pk_bf16_f32 v27, v116, v117
    v_cvt_pk_bf16_f32 v112, v112, v112
    v_and_b32 v112, 0xffff0000, v112
    v_and_b32_dpp v120, v27, v231 row_newbcast:0 row_mask:0xf bank_mask:0xf
    v_and_b32_dpp v121, v27, v231 row_newbcast:2 row_mask:0xf bank_mask:0xf
    v_and_b32_dpp v122, v27, v231 row_newbcast:4 row_mask:0xf bank_mask:0xf
    v_and_b32_dpp v123, v27, v231 row_newbcast:6 row_mask:0xf bank_mask:0xf
    v_and_b32_dpp v124, v27, v232 row_newbcast:0 row_mask:0xf bank_mask:0xf
    v_and_b32_dpp v125, v27, v232 row_newbcast:2 row_mask:0xf bank_mask:0xf
    v_and_b32_dpp v126, v27, v232 row_newbcast:4 row_mask:0xf bank_mask:0xf
    v_and_b32_dpp v127, v27, v232 row_newbcast:6 row_mask:0xf bank_mask:0xf
    v_mfma_f32_16x16x32_bf16 v[8:11], v[120:123], v[180:183], 0
    v_mfma_f32_16x16x32_bf16 v[12:15], v[120:123], v[184:187], 0
    v_and_b32_dpp v128, v27, v233 row_newbcast:0 row_mask:0xf bank_mask:0xf
    v_and_b32_dpp v129, v27, v233 row_newbcast:2 row_mask:0xf bank_mask:0xf
    v_and_b32_dpp v130, v27, v233 row_newbcast:4 row_mask:0xf bank_mask:0xf
    v_and_b32_dpp v131, v27, v233 row_newbcast:6 row_mask:0xf bank_mask:0xf
    v_mfma_f32_16x16x32_bf16 v[16:19], v[120:123], v[188:191], 0
    v_add_f32 v112, 925353388, v112
    v_mfma_f32_16x16x32_bf16 v[20:23], v[120:123], v[192:195], 0
    v_cvt_pk_bf16_f32 v112, v112, v112
    v_mfma_f32_16x16x32_bf16 v[8:11], v[124:127], v[196:199], v[8:11]
    v_and_b32 v112, 0xffff0000, v112
    v_mfma_f32_16x16x32_bf16 v[12:15], v[124:127], v[200:203], v[12:15]
    v_sqrt_f32 v112, v112
    v_mfma_f32_16x16x32_bf16 v[16:19], v[124:127], v[204:207], v[16:19]
    v_cvt_pk_bf16_f32 v112, v112, v112
    v_mfma_f32_16x16x32_bf16 v[20:23], v[124:127], v[208:211], v[20:23]
    v_and_b32 v112, 0xffff0000, v112
    v_mfma_f32_16x16x32_bf16 v[8:11], v[128:131], v[212:215], v[8:11]
    v_rcp_f32 v112, v112
    v_mfma_f32_16x16x32_bf16 v[12:15], v[128:131], v[216:219], v[12:15]

    s_nop 1
    v_mul_f32 v110, v16, v112
    v_mul_f32_dpp v108, v16, v112 row_ror:8 row_mask:0xf bank_mask:0xc
    v_mul_f32 v111, v20, v112
    v_mul_f32_dpp v109, v20, v112 row_ror:8 row_mask:0xf bank_mask:0xc
    v_mul_f32_dpp v110, v8, v112 row_ror:8 row_mask:0xf bank_mask:0x3
    v_mul_f32_dpp v108, v8, v112 quad_perm:[0,1,2,3] row_mask:0xf bank_mask:0x3
    v_mul_f32_dpp v111, v12, v112 row_ror:8 row_mask:0xf bank_mask:0x3
    v_mul_f32_dpp v109, v12, v112 quad_perm:[0,1,2,3] row_mask:0xf bank_mask:0x3
    s_mov_b32 exec_hi, 0xff
    v_perm_b32 v244, v108, v111, s40
    v_perm_b32 v245, v109, v111, s41
    v_perm_b32 v246, v110, v111, s42
    global_store_dwordx4 v229, v[244:247], s[24:25] sc1
    s_branch L_DONE
L_FIN:
    s_cmp_ge_u32 s26, 1
    s_cbranch_scc1 L_DONE
    s_load_dwordx2 s[20:21], s[0:1], 64

    s_lshl_b32 s34, s49, 13
    s_add_u32 s34, s34, 528384
    v_lshl_add_u32 v225, v1, 4, s34

    s_lshl_b32 s34, s49, 5
    v_and_b32 v248, 7, v1
    v_lshl_add_u32 v249, v4, 3, v248
    v_add_u32 v249, s34, v249
    v_lshlrev_b32 v227, 1, v249
    global_load_ushort v228, v227, s[4:5]
    s_mul_i32 s34, s28, 20480
    s_add_u32 s34, s34, 723456
    v_lshrrev_b32 v250, 2, v249
    v_lshl_add_u32 v221, v250, 4, s34
    v_add_u32 v222, 7680, v221
    v_add_u32 v223, 15360, v221
    global_load_dwordx4 v[28:31], v221, s[24:25] offset:-2560 sc1
    global_load_dwordx4 v[32:35], v221, s[24:25] offset:0 sc1
    global_load_dwordx4 v[36:39], v221, s[24:25] offset:2560 sc1
    global_load_dwordx4 v[40:43], v222, s[24:25] offset:-2560 sc1
    global_load_dwordx4 v[44:47], v222, s[24:25] offset:0 sc1
    global_load_dwordx4 v[48:51], v222, s[24:25] offset:2560 sc1
    global_load_dwordx4 v[52:55], v223, s[24:25] offset:-2560 sc1
    global_load_dwordx4 v[56:59], v223, s[24:25] offset:0 sc1
    v_and_b32 v250, 1, v249
    v_cmp_eq_u32 s[4:5], 1, v250
    v_and_b32 v250, 2, v249
    v_cmp_eq_u32 s[6:7], 2, v250
    v_mov_b32 v164, 0
    v_mov_b32 v165, 0
    v_mov_b32 v166, 0
    v_mov_b32 v167, s27
    v_mov_b32 v192, 0
    v_mov_b32 v193, 0
    v_mov_b32 v194, 0
    v_mov_b32 v195, s27
    s_branch L_YCHKF
L_YPOLLF:
    global_load_dwordx4 v[28:31], v221, s[24:25] offset:-2560 sc1
    global_load_dwordx4 v[32:35], v221, s[24:25] offset:0 sc1
    global_load_dwordx4 v[36:39], v221, s[24:25] offset:2560 sc1
    global_load_dwordx4 v[40:43], v222, s[24:25] offset:-2560 sc1
    global_load_dwordx4 v[44:47], v222, s[24:25] offset:0 sc1
    global_load_dwordx4 v[48:51], v222, s[24:25] offset:2560 sc1
    global_load_dwordx4 v[52:55], v223, s[24:25] offset:-2560 sc1
    global_load_dwordx4 v[56:59], v223, s[24:25] offset:0 sc1
    s_sub_u32 s48, s48, 1
    s_cbranch_scc1 L_YOKF
L_YCHKF:
    s_waitcnt vmcnt(7)
    v_xor_b32 v5, s27, v31
    v_perm_b32 v31, v29, v28, s43
    v_lshl_or_b32 v31, v30, 24, v31
    s_waitcnt vmcnt(6)
    v_bitop3_b32 v5, v5, v35, s27 bitop3:0xf6
    v_perm_b32 v35, v33, v32, s43
    v_lshl_or_b32 v35, v34, 24, v35
    v_pk_add_f32 v[108:109], v[28:29], v[32:33]
    v_pk_add_f32 v[110:111], v[30:31], v[34:35]
    s_waitcnt vmcnt(5)
    v_bitop3_b32 v5, v5, v39, s27 bitop3:0xf6
    v_perm_b32 v39, v37, v36, s43
    v_lshl_or_b32 v39, v38, 24, v39
    v_pk_add_f32 v[108:109], v[108:109], v[36:37]
    v_pk_add_f32 v[110:111], v[110:111], v[38:39]
    s_waitcnt vmcnt(4)
    v_bitop3_b32 v5, v5, v43, s27 bitop3:0xf6
    v_perm_b32 v43, v41, v40, s43
    v_lshl_or_b32 v43, v42, 24, v43
    v_pk_add_f32 v[108:109], v[108:109], v[40:41]
    v_pk_add_f32 v[110:111], v[110:111], v[42:43]
    s_waitcnt vmcnt(3)
    v_bitop3_b32 v5, v5, v47, s27 bitop3:0xf6
    v_perm_b32 v47, v45, v44, s43
    v_lshl_or_b32 v47, v46, 24, v47
    v_pk_add_f32 v[108:109], v[108:109], v[44:45]
    v_pk_add_f32 v[110:111], v[110:111], v[46:47]
    s_waitcnt vmcnt(2)
    v_bitop3_b32 v5, v5, v51, s27 bitop3:0xf6
    v_perm_b32 v51, v49, v48, s43
    v_lshl_or_b32 v51, v50, 24, v51
    v_pk_add_f32 v[108:109], v[108:109], v[48:49]
    v_pk_add_f32 v[110:111], v[110:111], v[50:51]
    s_waitcnt vmcnt(1)
    v_bitop3_b32 v5, v5, v55, s27 bitop3:0xf6
    v_perm_b32 v55, v53, v52, s43
    v_lshl_or_b32 v55, v54, 24, v55
    v_pk_add_f32 v[108:109], v[108:109], v[52:53]
    v_pk_add_f32 v[110:111], v[110:111], v[54:55]
    s_waitcnt vmcnt(0)
    v_bitop3_b32 v5, v5, v59, s27 bitop3:0xf6
    v_perm_b32 v59, v57, v56, s43
    v_lshl_or_b32 v59, v58, 24, v59
    v_pk_add_f32 v[108:109], v[108:109], v[56:57]
    v_pk_add_f32 v[110:111], v[110:111], v[58:59]
    v_cmp_ne_u32 vcc, 0, v5
    s_cbranch_vccnz L_YPOLLF
L_YOKF:
    s_cmp_lg_u32 s49, 0
    s_cbranch_scc1 L_NOTAG
    s_mov_b64 exec, 1
    v_mov_b32 v248, 0
    global_store_dword v248, v247, s[24:25] sc1
    s_mov_b64 exec, -1
L_NOTAG:
    global_load_dwordx4 v[140:143], v225, s[24:25] offset:-4096 sc1
    global_load_dwordx4 v[144:147], v225, s[24:25] offset:-3072 sc1
    global_load_dwordx4 v[148:151], v225, s[24:25] offset:-2048 sc1
    global_load_dwordx4 v[152:155], v225, s[24:25] offset:-1024 sc1
    global_load_dwordx4 v[156:159], v225, s[24:25] offset:0 sc1
    global_load_dwordx4 v[160:163], v225, s[24:25] offset:1024 sc1
    s_mov_b32 exec_hi, 0xffff
    global_load_dwordx4 v[164:167], v225, s[24:25] offset:2048 sc1
    s_mov_b32 exec_hi, -1
    v_cndmask_b32 v108, v108, v109, s[4:5]
    v_cndmask_b32 v110, v110, v111, s[4:5]
    v_cndmask_b32 v108, v108, v110, s[6:7]
    v_lshlrev_b32 v228, 16, v228
    v_cvt_pk_bf16_f32 v108, v108, v108
    v_and_b32 v108, 0xffff0000, v108
    v_add_f32 v228, v228, v108
    v_cvt_pk_bf16_f32 v228, v228, v228
    v_and_b32 v228, 0xffff0000, v228
    s_movk_i32 s48, 32767
    s_waitcnt lgkmcnt(0)
L_PPOLL:
    global_load_dwordx4 v[168:171], v225, s[24:25] offset:-4096 sc1
    global_load_dwordx4 v[172:175], v225, s[24:25] offset:-3072 sc1
    global_load_dwordx4 v[176:179], v225, s[24:25] offset:-2048 sc1
    global_load_dwordx4 v[180:183], v225, s[24:25] offset:-1024 sc1
    global_load_dwordx4 v[184:187], v225, s[24:25] offset:0 sc1
    global_load_dwordx4 v[188:191], v225, s[24:25] offset:1024 sc1
    s_mov_b32 exec_hi, 0xffff
    global_load_dwordx4 v[192:195], v225, s[24:25] offset:2048 sc1
    s_mov_b32 exec_hi, -1
    s_waitcnt vmcnt(13)
    v_xor_b32 v5, s27, v143
    v_perm_b32 v143, v141, v140, s43
    v_lshl_or_b32 v143, v142, 24, v143
    s_waitcnt vmcnt(12)
    v_bitop3_b32 v5, v5, v147, s27 bitop3:0xf6
    v_perm_b32 v147, v145, v144, s43
    v_lshl_or_b32 v147, v146, 24, v147
    v_pk_add_f32 v[108:109], v[140:141], v[144:145]
    v_pk_add_f32 v[110:111], v[142:143], v[146:147]
    s_waitcnt vmcnt(11)
    v_bitop3_b32 v5, v5, v151, s27 bitop3:0xf6
    v_perm_b32 v151, v149, v148, s43
    v_lshl_or_b32 v151, v150, 24, v151
    v_pk_add_f32 v[108:109], v[108:109], v[148:149]
    v_pk_add_f32 v[110:111], v[110:111], v[150:151]
    s_waitcnt vmcnt(10)
    v_bitop3_b32 v5, v5, v155, s27 bitop3:0xf6
    v_perm_b32 v155, v153, v152, s43
    v_lshl_or_b32 v155, v154, 24, v155
    v_pk_add_f32 v[108:109], v[108:109], v[152:153]
    v_pk_add_f32 v[110:111], v[110:111], v[154:155]
    s_waitcnt vmcnt(9)
    v_bitop3_b32 v5, v5, v159, s27 bitop3:0xf6
    v_perm_b32 v159, v157, v156, s43
    v_lshl_or_b32 v159, v158, 24, v159
    v_pk_add_f32 v[108:109], v[108:109], v[156:157]
    v_pk_add_f32 v[110:111], v[110:111], v[158:159]
    s_waitcnt vmcnt(8)
    v_bitop3_b32 v5, v5, v163, s27 bitop3:0xf6
    v_perm_b32 v163, v161, v160, s43
    v_lshl_or_b32 v163, v162, 24, v163
    v_pk_add_f32 v[108:109], v[108:109], v[160:161]
    v_pk_add_f32 v[110:111], v[110:111], v[162:163]
    s_waitcnt vmcnt(7)
    v_bitop3_b32 v5, v5, v167, s27 bitop3:0xf6
    v_perm_b32 v115, v165, v164, s43
    v_cmp_ne_u32 vcc, 0, v5
    v_pk_add_f32 v[108:109], v[108:109], v[164:165]
    v_lshl_or_b32 v115, v166, 24, v115
    v_add_f32 v110, v110, v166
    v_add_f32 v111, v111, v115
    s_cbranch_vccz L_POK
    global_load_dwordx4 v[140:143], v225, s[24:25] offset:-4096 sc1
    global_load_dwordx4 v[144:147], v225, s[24:25] offset:-3072 sc1
    global_load_dwordx4 v[148:151], v225, s[24:25] offset:-2048 sc1
    global_load_dwordx4 v[152:155], v225, s[24:25] offset:-1024 sc1
    global_load_dwordx4 v[156:159], v225, s[24:25] offset:0 sc1
    global_load_dwordx4 v[160:163], v225, s[24:25] offset:1024 sc1
    s_mov_b32 exec_hi, 0xffff
    global_load_dwordx4 v[164:167], v225, s[24:25] offset:2048 sc1
    s_mov_b32 exec_hi, -1
    s_sub_u32 s48, s48, 1
    s_cbranch_scc1 L_POK
    s_waitcnt vmcnt(13)
    v_xor_b32 v5, s27, v171
    v_perm_b32 v171, v169, v168, s43
    v_lshl_or_b32 v171, v170, 24, v171
    s_waitcnt vmcnt(12)
    v_bitop3_b32 v5, v5, v175, s27 bitop3:0xf6
    v_perm_b32 v175, v173, v172, s43
    v_lshl_or_b32 v175, v174, 24, v175
    v_pk_add_f32 v[108:109], v[168:169], v[172:173]
    v_pk_add_f32 v[110:111], v[170:171], v[174:175]
    s_waitcnt vmcnt(11)
    v_bitop3_b32 v5, v5, v179, s27 bitop3:0xf6
    v_perm_b32 v179, v177, v176, s43
    v_lshl_or_b32 v179, v178, 24, v179
    v_pk_add_f32 v[108:109], v[108:109], v[176:177]
    v_pk_add_f32 v[110:111], v[110:111], v[178:179]
    s_waitcnt vmcnt(10)
    v_bitop3_b32 v5, v5, v183, s27 bitop3:0xf6
    v_perm_b32 v183, v181, v180, s43
    v_lshl_or_b32 v183, v182, 24, v183
    v_pk_add_f32 v[108:109], v[108:109], v[180:181]
    v_pk_add_f32 v[110:111], v[110:111], v[182:183]
    s_waitcnt vmcnt(9)
    v_bitop3_b32 v5, v5, v187, s27 bitop3:0xf6
    v_perm_b32 v187, v185, v184, s43
    v_lshl_or_b32 v187, v186, 24, v187
    v_pk_add_f32 v[108:109], v[108:109], v[184:185]
    v_pk_add_f32 v[110:111], v[110:111], v[186:187]
    s_waitcnt vmcnt(8)
    v_bitop3_b32 v5, v5, v191, s27 bitop3:0xf6
    v_perm_b32 v191, v189, v188, s43
    v_lshl_or_b32 v191, v190, 24, v191
    v_pk_add_f32 v[108:109], v[108:109], v[188:189]
    v_pk_add_f32 v[110:111], v[110:111], v[190:191]
    s_waitcnt vmcnt(7)
    v_bitop3_b32 v5, v5, v195, s27 bitop3:0xf6
    v_perm_b32 v115, v193, v192, s43
    v_cmp_ne_u32 vcc, 0, v5
    v_pk_add_f32 v[108:109], v[108:109], v[192:193]
    v_lshl_or_b32 v115, v194, 24, v115
    v_add_f32 v110, v110, v194
    v_add_f32 v111, v111, v115
    s_cbranch_vccnz L_PPOLL
L_POK:
    v_permlane32_swap_b32 v108, v109
    v_permlane32_swap_b32 v110, v111
    v_add_f32 v108, v108, v109
    v_add_f32 v110, v110, v111
    s_nop 1
    v_permlane16_swap_b32 v108, v110
    v_add_f32 v108, v108, v110
    s_nop 1
    v_add_f32_dpp v108, v108, v108 row_ror:8 row_mask:0xf bank_mask:0xf
    s_mov_b32 exec_lo, 0x00ff00ff
    s_mov_b32 exec_hi, 0x00ff00ff
    v_cvt_pk_bf16_f32 v108, v108, v108
    v_and_b32 v108, 0xffff0000, v108
    v_add_f32 v108, v108, v228
    v_cvt_pk_bf16_f32 v108, v108, v108
    global_store_short v227, v108, s[20:21]
L_DONE:
L_END:
    s_endpgm
    .fill (16896 - (. - sequential_preLN__sliding_block_cached__dense_activation_relu__decode_kernel)) / 4, 4, 0xbf810000

.section .rodata,"a"
.p2align 6
.amdhsa_kernel sequential_preLN__sliding_block_cached__dense_activation_relu__decode_kernel
  .amdhsa_next_free_vgpr 256
  .amdhsa_next_free_sgpr 102
  .amdhsa_accum_offset 256
  .amdhsa_group_segment_fixed_size 0
  .amdhsa_kernarg_size 88
  .amdhsa_user_sgpr_count 2
  .amdhsa_user_sgpr_kernarg_segment_ptr 1
  .amdhsa_system_sgpr_workgroup_id_x 1
.end_amdhsa_kernel
```
